```python
import torch

def _softmax(x, axis=-1):
    return torch.softmax(x, dim=axis)
def _gelu(x):
    return torch.nn.functional.gelu(x, approximate="tanh")
def _silu(x):
    return torch.nn.functional.silu(x)
def _sigmoid(x):
    return torch.sigmoid(x)
def _layernorm(x, axis=-1, eps=1e-5):
    m = x.mean(dim=axis, keepdim=True)
    v = x.var(dim=axis, keepdim=True, unbiased=False)
    return (x - m) / torch.sqrt(v + eps)
def _scatter_add(tgt, idx, src, axis=0):
    return tgt.clone().index_add_(axis, idx, src)
def _segment_sum(src, seg, n):
    out = torch.zeros((n,) + src.shape[1:], dtype=src.dtype)
    return out.index_add_(0, seg, src)
def _pad(x, pw):
    flat = tuple(v for pair in reversed(pw) for v in pair)
    return torch.nn.functional.pad(x, flat)

kernel_name = 'standalone__mpnn_edge_mlp__graph'

def setup_inputs():

    _w = (lambda a: (lambda t: t.to(torch.bfloat16) if t.is_floating_point() else t)(torch.as_tensor(a)))
    N, deg, D, De = 50000, 16, 64, max(0, 1)
    E = N * deg
    return {
        "x": _w((lambda *s: torch.randn(*s, dtype=torch.bfloat16) * 0.05)(N, D)),
        "e_attr": _w((lambda *s: torch.randn(*s, dtype=torch.bfloat16) * 0.8)(E, De)),
        "src": _w((lambda lo, hi, *s: torch.randint(lo, hi, s))(0, N, E).to(torch.int64)),
        "dst": _w((lambda lo, hi, *s: torch.randint(lo, hi, s))(0, N, E).to(torch.int64)),
        "w_msg": _w((lambda *s: torch.randn(*s, dtype=torch.bfloat16) * 0.8)(2 * D + De, D)),
        "w_upd": _w((lambda *s: torch.randn(*s, dtype=torch.bfloat16) * 0.05)(2 * D, D)),
    }

def reference(x, e_attr, src, dst, w_msg, w_upd):
    N, D = x.shape
    m_in = torch.concatenate([x[src], x[dst], e_attr], axis=-1)
    msg = _silu(m_in @ w_msg)
    agg = _segment_sum(msg, dst, N)
    return _silu(torch.concatenate([x, agg], axis=-1) @ w_upd)
```

```asm
; @launch kernel=k1_kernel grid=(513,1,1) block=(512,1,1) lds=40448
; @launch kernel=k2_kernel grid=(256,1,1) block=(1024,1,1) lds=154688
.amdgcn_target "amdgcn-amd-amdhsa--gfx950"
.text
    .globl k1_kernel
    .p2align 8
    .type k1_kernel,@function
k1_kernel:
    s_cmp_ge_u32 s2, 513
    s_cbranch_scc1 K1_END
    s_load_dwordx4 s[4:7], s[0:1], 0
    s_load_dwordx4 s[8:11], s[0:1], 16
    s_load_dwordx4 s[12:15], s[0:1], 32
    s_load_dwordx2 s[16:17], s[0:1], 64
    s_cmp_ge_u32 s2, 512
    s_cbranch_scc1 K1_PREP
    s_cmp_ge_u32 s2, 256
    s_cbranch_scc1 K1_PWG
    v_lshlrev_b32 v1, 2, v0
    s_mul_i32 s3, s2, 3136
    v_add_u32 v2, s3, v1
    v_and_b32 v3, 255, v0
    v_lshlrev_b32 v3, 2, v3
    v_mov_b32 v4, 0
    ds_write_b32 v3, v4 offset:0
    s_movk_i32 s18, 392
    v_cmp_gt_u32 s[28:29], s18, v0
    v_cmp_gt_u32 vcc, 800000, v2
    s_and_b64 s[20:21], s[28:29], vcc
    v_add_u32 v3, 1568, v2
    v_cmp_gt_u32 vcc, 800000, v3
    s_and_b64 s[28:29], s[28:29], vcc
    v_lshlrev_b32 v5, 2, v2
    v_lshlrev_b32 v6, 1, v2
    v_add_u32 v44, 6272, v5
    v_add_u32 v45, 3136, v6
    s_waitcnt lgkmcnt(0)
    s_mov_b64 s[22:23], exec
    s_mov_b64 exec, s[20:21]
    global_load_dwordx4 v[8:11], v5, s[10:11] nt
    s_mov_b64 exec, s[28:29]
    global_load_dwordx4 v[12:15], v44, s[10:11] nt
    s_mov_b64 exec, s[20:21]
    global_load_dwordx4 v[16:19], v5, s[8:9] nt
    global_load_dwordx2 v[24:25], v6, s[6:7] nt
    s_mov_b64 exec, s[28:29]
    global_load_dwordx4 v[20:23], v44, s[8:9] nt
    global_load_dwordx2 v[26:27], v45, s[6:7] nt
    s_mov_b64 exec, s[22:23]
    s_barrier
    s_mov_b32 s18, 85599
    s_mov_b32 s19, 4294967100
    s_mov_b32 s24, 0xffff0000
    v_mov_b32 v7, 1
    s_waitcnt vmcnt(4)
    s_mov_b64 exec, s[20:21]
    v_mul_u32_u24 v28, s18, v8
    v_lshrrev_b32 v28, 24, v28
    v_mad_i32_i24 v8, v28, s19, v8
    v_lshlrev_b32 v28, 2, v28
    ds_add_rtn_u32 v36, v28, v7 offset:0
    v_mul_u32_u24 v29, s18, v9
    v_lshrrev_b32 v29, 24, v29
    v_mad_i32_i24 v9, v29, s19, v9
    v_lshlrev_b32 v29, 2, v29
    ds_add_rtn_u32 v37, v29, v7 offset:0
    v_mul_u32_u24 v30, s18, v10
    v_lshrrev_b32 v30, 24, v30
    v_mad_i32_i24 v10, v30, s19, v10
    v_lshlrev_b32 v30, 2, v30
    ds_add_rtn_u32 v38, v30, v7 offset:0
    v_mul_u32_u24 v31, s18, v11
    v_lshrrev_b32 v31, 24, v31
    v_mad_i32_i24 v11, v31, s19, v11
    v_lshlrev_b32 v31, 2, v31
    ds_add_rtn_u32 v39, v31, v7 offset:0
    s_mov_b64 exec, s[28:29]
    v_mul_u32_u24 v32, s18, v12
    v_lshrrev_b32 v32, 24, v32
    v_mad_i32_i24 v12, v32, s19, v12
    v_lshlrev_b32 v32, 2, v32
    ds_add_rtn_u32 v40, v32, v7 offset:0
    v_mul_u32_u24 v33, s18, v13
    v_lshrrev_b32 v33, 24, v33
    v_mad_i32_i24 v13, v33, s19, v13
    v_lshlrev_b32 v33, 2, v33
    ds_add_rtn_u32 v41, v33, v7 offset:0
    v_mul_u32_u24 v34, s18, v14
    v_lshrrev_b32 v34, 24, v34
    v_mad_i32_i24 v14, v34, s19, v14
    v_lshlrev_b32 v34, 2, v34
    ds_add_rtn_u32 v42, v34, v7 offset:0
    v_mul_u32_u24 v35, s18, v15
    v_lshrrev_b32 v35, 24, v35
    v_mad_i32_i24 v15, v35, s19, v15
    v_lshlrev_b32 v35, 2, v35
    ds_add_rtn_u32 v43, v35, v7 offset:0
    s_mov_b64 exec, s[22:23]
    s_waitcnt vmcnt(0)
    v_lshl_or_b32 v16, v24, 16, v16
    v_and_or_b32 v17, v24, s24, v17
    v_lshl_or_b32 v18, v25, 16, v18
    v_and_or_b32 v19, v25, s24, v19
    v_lshl_or_b32 v20, v26, 16, v20
    v_and_or_b32 v21, v26, s24, v21
    v_lshl_or_b32 v22, v27, 16, v22
    v_and_or_b32 v23, v27, s24, v23
    s_waitcnt lgkmcnt(0)
    s_barrier
    v_readfirstlane_b32 s25, v0
    s_cmp_ge_u32 s25, 64
    s_cbranch_scc1 K1_BIN_NOSCAN
    v_lshlrev_b32 v44, 4, v0
    ds_read_b128 v[48:51], v44 offset:0
    s_waitcnt lgkmcnt(0)
    v_add_u32 v52, v48, v49
    v_add_u32 v53, v52, v50
    v_add_u32 v54, v53, v51
    v_mov_b32 v55, v54
    s_nop 1
    v_add_u32_dpp v55, v55, v55 row_shr:1 row_mask:0xf bank_mask:0xf bound_ctrl:1
    s_nop 1
    v_add_u32_dpp v55, v55, v55 row_shr:2 row_mask:0xf bank_mask:0xf bound_ctrl:1
    s_nop 1
    v_add_u32_dpp v55, v55, v55 row_shr:4 row_mask:0xf bank_mask:0xf bound_ctrl:1
    s_nop 1
    v_add_u32_dpp v55, v55, v55 row_shr:8 row_mask:0xf bank_mask:0xf bound_ctrl:1
    s_nop 1
    v_add_u32_dpp v55, v55, v55 row_bcast:15 row_mask:0xa bank_mask:0xf
    s_nop 1
    v_add_u32_dpp v55, v55, v55 row_bcast:31 row_mask:0xc bank_mask:0xf
    v_sub_u32 v56, v55, v54
    v_add_u32 v57, v56, v48
    v_add_u32 v58, v56, v52
    v_add_u32 v59, v56, v53
    ds_write_b128 v44, v[56:59] offset:1024
    v_lshl_or_b32 v48, v48, 16, v56
    v_lshl_or_b32 v49, v49, 16, v57
    v_lshl_or_b32 v50, v50, 16, v58
    v_lshl_or_b32 v51, v51, 16, v59
    s_lshl_b32 s26, s2, 10
    s_add_u32 s26, s26, 6553600
    v_add_u32 v45, s26, v44
    global_store_dwordx4 v45, v[48:51], s[16:17] sc1
    s_waitcnt lgkmcnt(0)
K1_BIN_NOSCAN:
    s_barrier
    s_mov_b64 exec, s[20:21]
    ds_read_b32 v28, v28 offset:1024
    ds_read_b32 v29, v29 offset:1024
    ds_read_b32 v30, v30 offset:1024
    ds_read_b32 v31, v31 offset:1024
    s_mov_b64 exec, s[28:29]
    ds_read_b32 v32, v32 offset:1024
    ds_read_b32 v33, v33 offset:1024
    ds_read_b32 v34, v34 offset:1024
    ds_read_b32 v35, v35 offset:1024
    s_mov_b64 exec, s[22:23]
    s_waitcnt lgkmcnt(0)
    v_add_lshl_u32 v28, v28, v36, 3
    v_mov_b32 v44, v16
    v_lshlrev_b32 v45, 2, v8
    v_add_lshl_u32 v29, v29, v37, 3
    v_mov_b32 v46, v17
    v_lshlrev_b32 v47, 2, v9
    v_add_lshl_u32 v30, v30, v38, 3
    v_mov_b32 v48, v18
    v_lshlrev_b32 v49, 2, v10
    v_add_lshl_u32 v31, v31, v39, 3
    v_mov_b32 v50, v19
    v_lshlrev_b32 v51, 2, v11
    v_add_lshl_u32 v32, v32, v40, 3
    v_mov_b32 v52, v20
    v_lshlrev_b32 v53, 2, v12
    v_add_lshl_u32 v33, v33, v41, 3
    v_mov_b32 v54, v21
    v_lshlrev_b32 v55, 2, v13
    v_add_lshl_u32 v34, v34, v42, 3
    v_mov_b32 v56, v22
    v_lshlrev_b32 v57, 2, v14
    v_add_lshl_u32 v35, v35, v43, 3
    v_mov_b32 v58, v23
    v_lshlrev_b32 v59, 2, v15
    s_mov_b64 exec, s[20:21]
    ds_write_b64 v28, v[44:45] offset:2048
    ds_write_b64 v29, v[46:47] offset:2048
    ds_write_b64 v30, v[48:49] offset:2048
    ds_write_b64 v31, v[50:51] offset:2048
    s_mov_b64 exec, s[28:29]
    ds_write_b64 v32, v[52:53] offset:2048
    ds_write_b64 v33, v[54:55] offset:2048
    ds_write_b64 v34, v[56:57] offset:2048
    ds_write_b64 v35, v[58:59] offset:2048
    s_mov_b64 exec, s[22:23]
    s_waitcnt lgkmcnt(0)
    s_barrier
    v_lshlrev_b32 v1, 4, v0
    s_mul_i32 s26, s2, 25088
    s_add_u32 s26, s26, 0
    v_add_u32 v2, s26, v1
    ds_read_b128 v[8:11], v1 offset:2048
    ds_read_b128 v[12:15], v1 offset:10240
    ds_read_b128 v[16:19], v1 offset:18432
    v_cmp_gt_u32 vcc, 32, v0
    s_and_saveexec_b64 s[22:23], vcc
    s_cbranch_execz K1_BIN_SK4
    ds_read_b128 v[20:23], v1 offset:26624
    v_add_u32 v3, 24576, v2
    s_waitcnt lgkmcnt(0)
    global_store_dwordx4 v3, v[20:23], s[16:17] sc1
K1_BIN_SK4:
    s_mov_b64 exec, s[22:23]
    v_add_u32 v3, 8192, v2
    v_add_u32 v4, 16384, v2
    s_waitcnt lgkmcnt(0)
    global_store_dwordx4 v2, v[8:11], s[16:17] sc1
    global_store_dwordx4 v3, v[12:15], s[16:17] sc1
    global_store_dwordx4 v4, v[16:19], s[16:17] sc1
    s_endpgm
K1_PWG:
    s_sub_u32 s2, s2, 256
    v_lshlrev_b32 v1, 4, v0
    v_lshrrev_b32 v2, 6, v0
    s_mul_i32 s18, s2, 196
    v_readfirstlane_b32 s3, v2
    s_nop 0
    s_mul_i32 s18, s2, 196
    s_lshl_b32 s19, s18, 7
    v_add_u32 v14, s19, v1
    v_lshrrev_b32 v15, 3, v0
    v_mul_u32_u24 v15, 144, v15
    v_and_b32 v13, 7, v0
    v_lshl_add_u32 v15, v13, 4, v15
    s_waitcnt lgkmcnt(0)
    global_load_dwordx4 v[8:11], v1, s[12:13]
    s_mov_b32 s20, s4
    s_and_b32 s21, s5, 0xffff
    s_mov_b32 s22, 6400000
    s_mov_b32 s23, 0x20000
    buffer_load_dwordx4 v[16:19], v14, s[20:23], 0 offen nt
    v_add_u32 v12, 8192, v14
    buffer_load_dwordx4 v[20:23], v12, s[20:23], 0 offen nt
    v_add_u32 v12, 16384, v14
    buffer_load_dwordx4 v[24:27], v12, s[20:23], 0 offen nt
    v_add_u32 v12, 24576, v14
    v_cmp_gt_u32 s[30:31], 32, v0
    s_mov_b64 exec, s[30:31]
    buffer_load_dwordx4 v[28:31], v12, s[20:23], 0 offen nt
    s_mov_b64 exec, -1
    s_add_u32 s24, s16, 7340032
    s_addc_u32 s25, s17, 0
    s_and_b32 s25, s25, 0xffff
    s_mov_b32 s26, 6400000
    s_mov_b32 s27, 0x20000
    s_lshl_b32 s19, s3, 5
    v_and_b32 v3, 31, v0
    v_add_u32 v4, s19, v3
    v_add_u32 v5, s18, v4
    v_bfe_u32 v6, v0, 5, 1
    v_lshlrev_b32 v7, 7, v5
    s_waitcnt vmcnt(4)
    ds_write_b128 v1, v[8:11]
    s_waitcnt vmcnt(3)
    ds_write_b128 v15, v[16:19] offset:8192
    s_waitcnt vmcnt(2)
    ds_write_b128 v15, v[20:23] offset:17408
    s_waitcnt vmcnt(1)
    ds_write_b128 v15, v[24:27] offset:26624
    s_waitcnt vmcnt(0)
    s_mov_b64 exec, s[30:31]
    ds_write_b128 v15, v[28:31] offset:35840
    s_mov_b64 exec, -1
    s_waitcnt lgkmcnt(0)
    s_barrier
    s_cmp_ge_u32 s3, 7
    s_cbranch_scc1 K1_END
    s_mov_b32 s20, s19
    s_mov_b32 s21, s18
    v_mul_u32_u24 v12, 144, v4
    v_lshl_add_u32 v12, v6, 4, v12
    ds_read_b128 v[16:19], v12 offset:8192
    ds_read_b128 v[20:23], v12 offset:8224
    ds_read_b128 v[24:27], v12 offset:8256
    ds_read_b128 v[28:31], v12 offset:8288
    v_and_b32 v14, 63, v0
    v_bfe_u32 v13, v14, 2, 2
    v_bfe_u32 v15, v14, 5, 1
    v_lshl_add_u32 v13, v15, 3, v13
    v_lshlrev_b32 v13, 7, v13
    v_and_b32 v15, 1, v14
    v_lshl_add_u32 v13, v15, 6, v13
    v_bfe_u32 v15, v14, 4, 1
    v_lshl_add_u32 v13, v15, 4, v13
    v_bfe_u32 v15, v14, 1, 1
    v_lshl_add_u32 v13, v15, 3, v13
    ds_read_b64_tr_b16 v[32:33], v13 offset:0
    ds_read_b64_tr_b16 v[34:35], v13 offset:512
    ds_read_b64_tr_b16 v[36:37], v13 offset:2048
    ds_read_b64_tr_b16 v[38:39], v13 offset:2560
    ds_read_b64_tr_b16 v[40:41], v13 offset:4096
    ds_read_b64_tr_b16 v[42:43], v13 offset:4608
    ds_read_b64_tr_b16 v[44:45], v13 offset:6144
    ds_read_b64_tr_b16 v[46:47], v13 offset:6656
    ds_read_b64_tr_b16 v[48:49], v13 offset:32
    ds_read_b64_tr_b16 v[50:51], v13 offset:544
    ds_read_b64_tr_b16 v[52:53], v13 offset:2080
    ds_read_b64_tr_b16 v[54:55], v13 offset:2592
    ds_read_b64_tr_b16 v[56:57], v13 offset:4128
    ds_read_b64_tr_b16 v[58:59], v13 offset:4640
    ds_read_b64_tr_b16 v[60:61], v13 offset:6176
    ds_read_b64_tr_b16 v[62:63], v13 offset:6688
    v_mov_b32 v64, 0
    v_mov_b32 v65, 0
    v_mov_b32 v66, 0
    v_mov_b32 v67, 0
    v_mov_b32 v68, 0
    v_mov_b32 v69, 0
    v_mov_b32 v70, 0
    v_mov_b32 v71, 0
    v_mov_b32 v72, 0
    v_mov_b32 v73, 0
    v_mov_b32 v74, 0
    v_mov_b32 v75, 0
    v_mov_b32 v76, 0
    v_mov_b32 v77, 0
    v_mov_b32 v78, 0
    v_mov_b32 v79, 0
    v_mov_b32 v80, 0
    v_mov_b32 v81, 0
    v_mov_b32 v82, 0
    v_mov_b32 v83, 0
    v_mov_b32 v84, 0
    v_mov_b32 v85, 0
    v_mov_b32 v86, 0
    v_mov_b32 v87, 0
    v_mov_b32 v88, 0
    v_mov_b32 v89, 0
    v_mov_b32 v90, 0
    v_mov_b32 v91, 0
    v_mov_b32 v92, 0
    v_mov_b32 v93, 0
    v_mov_b32 v94, 0
    v_mov_b32 v95, 0
    s_waitcnt lgkmcnt(0)
    v_mfma_f32_32x32x16_bf16 v[64:79], v[32:35], v[16:19], v[64:79]
    v_mfma_f32_32x32x16_bf16 v[80:95], v[48:51], v[16:19], v[80:95]
    v_mfma_f32_32x32x16_bf16 v[64:79], v[36:39], v[20:23], v[64:79]
    v_mfma_f32_32x32x16_bf16 v[80:95], v[52:55], v[20:23], v[80:95]
    v_mfma_f32_32x32x16_bf16 v[64:79], v[40:43], v[24:27], v[64:79]
    v_mfma_f32_32x32x16_bf16 v[80:95], v[56:59], v[24:27], v[80:95]
    v_mfma_f32_32x32x16_bf16 v[64:79], v[44:47], v[28:31], v[64:79]
    v_mfma_f32_32x32x16_bf16 v[80:95], v[60:63], v[28:31], v[80:95]
    s_nop 15
    s_mov_b32 s18, 3216550459
    s_mov_b32 s19, 3216550459
    v_pk_mul_f32 v[64:65], v[64:65], s[18:19]
    v_pk_mul_f32 v[66:67], v[66:67], s[18:19]
    v_pk_mul_f32 v[68:69], v[68:69], s[18:19]
    v_pk_mul_f32 v[70:71], v[70:71], s[18:19]
    v_pk_mul_f32 v[72:73], v[72:73], s[18:19]
    v_pk_mul_f32 v[74:75], v[74:75], s[18:19]
    v_pk_mul_f32 v[76:77], v[76:77], s[18:19]
    v_pk_mul_f32 v[78:79], v[78:79], s[18:19]
    v_pk_mul_f32 v[80:81], v[80:81], s[18:19]
    v_pk_mul_f32 v[82:83], v[82:83], s[18:19]
    v_pk_mul_f32 v[84:85], v[84:85], s[18:19]
    v_pk_mul_f32 v[86:87], v[86:87], s[18:19]
    v_pk_mul_f32 v[88:89], v[88:89], s[18:19]
    v_pk_mul_f32 v[90:91], v[90:91], s[18:19]
    v_pk_mul_f32 v[92:93], v[92:93], s[18:19]
    v_pk_mul_f32 v[94:95], v[94:95], s[18:19]
    v_cvt_pk_bf16_f32 v32, v64, v65
    v_cvt_pk_bf16_f32 v33, v66, v67
    v_cvt_pk_bf16_f32 v34, v68, v69
    v_cvt_pk_bf16_f32 v35, v70, v71
    v_cvt_pk_bf16_f32 v36, v72, v73
    v_cvt_pk_bf16_f32 v37, v74, v75
    v_cvt_pk_bf16_f32 v38, v76, v77
    v_cvt_pk_bf16_f32 v39, v78, v79
    v_cvt_pk_bf16_f32 v40, v80, v81
    v_cvt_pk_bf16_f32 v41, v82, v83
    v_cvt_pk_bf16_f32 v42, v84, v85
    v_cvt_pk_bf16_f32 v43, v86, v87
    v_cvt_pk_bf16_f32 v44, v88, v89
    v_cvt_pk_bf16_f32 v45, v90, v91
    v_cvt_pk_bf16_f32 v46, v92, v93
    v_cvt_pk_bf16_f32 v47, v94, v95
    v_mul_u32_u24 v12, 144, v4
    v_lshl_add_u32 v12, v6, 6, v12
    ds_write_b128 v12, v[32:35] offset:8192
    ds_write_b128 v12, v[36:39] offset:8208
    ds_write_b128 v12, v[40:43] offset:8224
    ds_write_b128 v12, v[44:47] offset:8240
    v_and_b32 v3, 63, v0
    v_lshrrev_b32 v13, 3, v3
    v_add_u32 v13, s20, v13
    v_and_b32 v14, 7, v0
    v_mul_u32_u24 v15, 144, v13
    v_lshl_add_u32 v15, v14, 4, v15
    v_add_u32 v12, s21, v13
    v_lshlrev_b32 v12, 7, v12
    v_lshl_add_u32 v12, v14, 4, v12
    s_waitcnt lgkmcnt(0)
    ds_read_b128 v[48:51], v15 offset:8192
    ds_read_b128 v[52:55], v15 offset:9344
    ds_read_b128 v[56:59], v15 offset:10496
    ds_read_b128 v[60:63], v15 offset:11648
    s_movk_i32 s28, 196
    v_add_u32 v16, 0, v13
    v_cmp_gt_u32 vcc, s28, v16
    s_and_saveexec_b64 s[30:31], vcc
    s_waitcnt lgkmcnt(3)
    buffer_store_dwordx4 v[48:51], v12, s[24:27], 0 offen offset:0 sc1
    s_mov_b64 exec, s[30:31]
    v_add_u32 v16, 8, v13
    v_cmp_gt_u32 vcc, s28, v16
    s_and_saveexec_b64 s[30:31], vcc
    s_waitcnt lgkmcnt(2)
    buffer_store_dwordx4 v[52:55], v12, s[24:27], 0 offen offset:1024 sc1
    s_mov_b64 exec, s[30:31]
    v_add_u32 v16, 16, v13
    v_cmp_gt_u32 vcc, s28, v16
    s_and_saveexec_b64 s[30:31], vcc
    s_waitcnt lgkmcnt(1)
    buffer_store_dwordx4 v[56:59], v12, s[24:27], 0 offen offset:2048 sc1
    s_mov_b64 exec, s[30:31]
    v_add_u32 v16, 24, v13
    v_cmp_gt_u32 vcc, s28, v16
    s_and_saveexec_b64 s[30:31], vcc
    s_waitcnt lgkmcnt(0)
    buffer_store_dwordx4 v[60:63], v12, s[24:27], 0 offen offset:3072 sc1
    s_mov_b64 exec, s[30:31]
    s_endpgm
K1_PREP:
    v_lshlrev_b32 v1, 4, v0
    v_lshrrev_b32 v2, 6, v0
    s_nop 0
    v_readfirstlane_b32 s3, v2
    s_waitcnt lgkmcnt(0)
    v_add_u32 v2, 8192, v1
    global_load_dwordx4 v[8:11], v2, s[12:13]
    global_load_dwordx4 v[12:15], v1, s[14:15]
    global_load_dwordx4 v[16:19], v2, s[14:15]
    s_waitcnt vmcnt(0)
    ds_write_b128 v1, v[8:11]
    ds_write_b128 v1, v[12:15] offset:8192
    ds_write_b128 v1, v[16:19] offset:16384
    s_waitcnt lgkmcnt(0)
    s_barrier
    v_and_b32 v14, 63, v0
    v_bfe_u32 v13, v14, 2, 2
    v_bfe_u32 v15, v14, 5, 1
    v_lshl_add_u32 v13, v15, 3, v13
    v_lshlrev_b32 v13, 7, v13
    v_and_b32 v15, 1, v14
    v_lshl_add_u32 v13, v15, 6, v13
    v_bfe_u32 v15, v14, 4, 1
    v_lshl_add_u32 v13, v15, 4, v13
    v_bfe_u32 v15, v14, 1, 1
    v_lshl_add_u32 v13, v15, 3, v13
    v_and_b32 v14, 63, v0
    v_bfe_u32 v12, v14, 2, 2
    v_bfe_u32 v15, v14, 5, 1
    v_lshl_add_u32 v12, v15, 3, v12
    v_lshlrev_b32 v12, 7, v12
    v_and_b32 v15, 1, v14
    v_lshl_add_u32 v12, v15, 5, v12
    v_bfe_u32 v15, v14, 4, 1
    v_lshl_add_u32 v12, v15, 4, v12
    v_bfe_u32 v15, v14, 1, 1
    v_lshl_add_u32 v12, v15, 3, v12
    v_and_b32 v1, 63, v0
    v_lshlrev_b32 v1, 4, v1
    s_lshr_b32 s21, s3, 2
    s_and_b32 s20, s3, 3
    s_lshl_b32 s20, s20, 11
    s_lshl_b32 s22, s21, 5
    s_add_u32 s22, s22, s20
    v_add_u32 v14, s22, v13
    ds_read_b64_tr_b16 v[16:17], v14
    ds_read_b64_tr_b16 v[18:19], v14 offset:512
    s_lshl_b32 s22, s21, 6
    s_add_u32 s22, s22, s20
    s_add_u32 s22, s22, 8192
    v_add_u32 v14, s22, v12
    ds_read_b64_tr_b16 v[20:21], v14
    ds_read_b64_tr_b16 v[22:23], v14 offset:512
    ds_read_b64_tr_b16 v[24:25], v14 offset:8192
    ds_read_b64_tr_b16 v[26:27], v14 offset:8704
    s_lshl_b32 s19, s3, 10
    s_add_u32 s19, s19, 14680064
    v_add_u32 v15, s19, v1
    s_waitcnt lgkmcnt(4)
    global_store_dwordx4 v15, v[16:19], s[16:17] sc1
    v_add_u32 v15, 8192, v15
    s_waitcnt lgkmcnt(2)
    global_store_dwordx4 v15, v[20:23], s[16:17] sc1
    v_add_u32 v15, 8192, v15
    s_waitcnt lgkmcnt(0)
    global_store_dwordx4 v15, v[24:27], s[16:17] sc1
    s_cmp_eq_u32 s3, 0
    s_cbranch_scc0 K1_END
    v_lshlrev_b32 v2, 1, v0
    v_add_u32 v2, 16384, v2
    global_load_ushort v3, v2, s[12:13]
    v_lshlrev_b32 v4, 2, v0
    v_add_u32 v4, 14704640, v4
    s_waitcnt vmcnt(0)
    v_lshlrev_b32 v3, 16, v3
    v_mul_f32 v3, 3216550459, v3
    global_store_dword v4, v3, s[16:17] sc1
K1_END:
    s_endpgm
    .globl k2_kernel
    .p2align 8
    .type k2_kernel,@function
k2_kernel:
    s_cmp_ge_u32 s2, 256
    s_cbranch_scc1 K2_END
    s_load_dwordx2 s[4:5], s[0:1], 0
    s_load_dwordx2 s[6:7], s[0:1], 32
    s_load_dwordx2 s[8:9], s[0:1], 48
    s_load_dwordx2 s[10:11], s[0:1], 64
    s_and_b32 s84, s2, 7
    s_lshl_b32 s84, s84, 5
    s_lshr_b32 s40, s2, 3
    s_add_u32 s84, s84, s40
    v_lshrrev_b32 v1, 6, v0
    s_mul_i32 s34, s84, 196
    v_readfirstlane_b32 s3, v1
    s_mov_b32 s28, 0
    s_lshl_b32 s40, s84, 2
    s_add_u32 s85, s40, 6553600
    s_add_u32 s86, s85, 0x20000
    v_lshrrev_b32 v29, 3, v0
    v_lshlrev_b32 v2, 10, v29
    v_and_b32 v28, 7, v0
    v_mul_u32_u24 v30, 25088, v29
    v_lshl_add_u32 v30, v28, 4, v30
    v_lshlrev_b32 v121, 4, v28
    v_lshlrev_b32 v28, 1, v28
    s_waitcnt lgkmcnt(0)
    s_mov_b32 s44, s10
    s_and_b32 s45, s11, 0xffff
    s_mov_b32 s46, 6815744
    s_mov_b32 s47, 0x20000
    buffer_load_dword v4, v2, s[44:47], s85 offen
    buffer_load_dword v5, v2, s[44:47], s86 offen
    s_mov_b32 s36, 3207688728
    s_mov_b32 s37, 3207688728
    s_movk_i32 s38, 0x207
    s_movk_i32 s35, 200
    s_movk_i32 s92, 4096
    s_mov_b32 s89, 0
    s_mov_b32 s90, 3211264
    s_mov_b32 s12, s4
    s_and_b32 s13, s5, 0xffff
    s_mov_b32 s14, 6400000
    s_mov_b32 s15, 0x20000
    s_mov_b32 s24, s8
    s_and_b32 s25, s9, 0xffff
    s_mov_b32 s26, 6400000
    s_mov_b32 s27, 0x20000
    s_add_u32 s16, s10, 7340032
    s_addc_u32 s17, s11, 0
    s_and_b32 s17, s17, 0xffff
    s_mov_b32 s20, s16
    s_mov_b32 s21, s17
    s_or_b32 s17, s17, 8388608
    s_mov_b32 s18, 50000
    s_mov_b32 s19, 0x20000
    s_mov_b32 s22, 6400000
    s_mov_b32 s23, 0x20000
    s_mov_b32 s93, 50000
    s_cmp_lt_u32 s3, 8
    s_mov_b32 s40, 0x13121110
    s_cmov_b32 s40, 0x1020600
    s_mov_b32 s41, 0x14151817
    s_cmov_b32 s41, 0x3040a07
    s_mov_b32 s42, 0xffff16ff
    s_cmov_b32 s42, 0xd0b0e0f
    s_mov_b32 s43, 0xffffffff
    s_cmov_b32 s43, 0x8050c09
    s_and_b32 s98, s3, 7
    s_lshl_b32 s98, s98, 3
    s_lshr_b64 s[40:41], s[40:41], s98
    s_lshr_b64 s[42:43], s[42:43], s98
    s_and_b32 s98, s40, 0xff
    s_and_b32 s99, s42, 0xff
    v_mov_b32 v113, v121
    v_mov_b32 v115, v121
    v_mov_b32 v116, 0
    v_mov_b32 v117, 0
    v_mov_b32 v125, 0
    v_mov_b32 v127, 0
    s_branch K2_PASS0
K2_PASS:
    buffer_load_dword v4, v2, s[44:47], s85 offen
    buffer_load_dword v5, v2, s[44:47], s86 offen
K2_PASS0:
    s_mov_b32 s33, s98
    s_mov_b32 s39, s99
    s_mov_b32 s96, s28
    s_mov_b32 s88, 1
    v_mov_b32 v3, 0
    v_lshlrev_b32 v1, 2, v0
    v_mul_u32_u24 v6, 160, v0
    v_add_u32 v6, 121920, v6
    v_cmp_gt_u32 vcc, 256, v0
    s_and_saveexec_b64 s[42:43], vcc
    ds_write_b32 v1, v6 offset:0
    v_cmp_gt_u32 vcc, 144, v0
    s_and_b64 exec, exec, vcc
    ds_write_b32 v1, v3 offset:2048
    s_mov_b64 exec, s[42:43]
    s_lshl_b32 s40, s28, 5
    v_add_u32 v31, s40, v28
    s_lshl_b32 s40, s28, 8
    v_add_u32 v1, s40, v30
    v_add_u32 v2, 1, v31
    v_add_u32 v3, 16, v31
    v_add_u32 v6, 17, v31
    v_add_u32 v7, 32, v31
    s_waitcnt lgkmcnt(0)
    s_barrier
    s_waitcnt vmcnt(0)
    v_mad_u32_u16 v96, v4, 8, v1
    v_cmp_lt_u32_sdwa s[52:53], v3, v4 src0_sel:DWORD src1_sel:WORD_1
    v_cmp_lt_u32_sdwa s[48:49], v31, v4 src0_sel:DWORD src1_sel:WORD_1
    v_cmp_lt_u32_sdwa vcc, v7, v4 src0_sel:DWORD src1_sel:WORD_1
    s_mov_b64 exec, s[52:53]
    buffer_load_dwordx4 v[100:103], v96, s[44:47], s89 offen offset:128
    s_mov_b64 exec, s[48:49]
    buffer_load_dwordx4 v[96:99], v96, s[44:47], s89 offen
    s_mov_b64 exec, -1
    s_mov_b64 s[40:41], vcc
    v_mad_u32_u16 v104, v5, 8, v1
    v_cmp_lt_u32_sdwa s[60:61], v3, v5 src0_sel:DWORD src1_sel:WORD_1
    v_cmp_lt_u32_sdwa s[56:57], v31, v5 src0_sel:DWORD src1_sel:WORD_1
    v_cmp_lt_u32_sdwa vcc, v7, v5 src0_sel:DWORD src1_sel:WORD_1
    s_mov_b64 exec, s[60:61]
    buffer_load_dwordx4 v[108:111], v104, s[44:47], s90 offen offset:128
    s_mov_b64 exec, s[56:57]
    buffer_load_dwordx4 v[104:107], v104, s[44:47], s90 offen
    s_mov_b64 exec, -1
    s_or_b64 s[40:41], s[40:41], vcc
    v_cmp_lt_u32_sdwa s[50:51], v2, v4 src0_sel:DWORD src1_sel:WORD_1
    v_cmp_lt_u32_sdwa s[54:55], v6, v4 src0_sel:DWORD src1_sel:WORD_1
    v_cmp_lt_u32_sdwa s[58:59], v2, v5 src0_sel:DWORD src1_sel:WORD_1
    v_cmp_lt_u32_sdwa s[62:63], v6, v5 src0_sel:DWORD src1_sel:WORD_1
    s_cmp_eq_u64 s[40:41], 0
    s_cbranch_scc1 K2_NOMORE
    v_mov_b32 v1, 2560
    v_mov_b32 v2, 1
    ds_write_b32 v1, v2
K2_NOMORE:
    s_cmp_lg_u32 s28, 0
    s_cbranch_scc1 K2_NOPRE
    v_and_b32 v3, 63, v0
    v_lshlrev_b32 v3, 4, v3
    s_lshl_b32 s42, s3, 10
    s_add_u32 s43, s42, 91328
    v_add_u32 v7, s43, v3
    s_add_u32 s43, s42, 113472
    v_add_u32 v126, s43, v3
    s_add_u32 s43, s42, 14680064
    v_add_u32 v127, s43, v3
    v_lshrrev_b32 v6, 3, v0
    v_mul_u32_u24 v6, 144, v6
    v_add_u32 v6, v6, v121
    v_add_u32 v6, 59072, v6
    s_lshl_b32 s42, s34, 7
    v_lshlrev_b32 v2, 4, v0
    v_add_u32 v125, s42, v2
    s_lshr_b32 s40, s3, 1
    s_lshl_b32 s40, s40, 5
    v_and_b32 v122, 31, v0
    v_add_u32 v122, s40, v122
    v_bfe_u32 v123, v0, 5, 1
    v_mul_u32_u24 v124, 272, v122
    v_lshl_add_u32 v124, v123, 6, v124
    s_and_b32 s41, s3, 1
    s_lshl_b32 s42, s41, 5
    v_add_u32 v124, s42, v124
    v_cmp_gt_u32 s[100:101], s35, v122
    v_mul_u32_u24 v122, 144, v122
    v_lshl_add_u32 v122, v123, 4, v122
    v_add_u32 v122, 59072, v122
    s_lshl_b32 s42, s41, 12
    s_add_u32 s42, s42, 91328
    v_add_u32 v123, s42, v3
    s_movk_i32 s42, 544
    v_cmp_gt_u32 s[94:95], s42, v0
K2_NOPRE:
    v_mov_b32 v1, 4
    s_waitcnt vmcnt(0)
    s_mov_b64 exec, s[48:49]
    ds_add_rtn_u32 v24, v97, v1 offset:0
    s_mov_b64 exec, s[50:51]
    ds_add_rtn_u32 v25, v99, v1 offset:0
    s_mov_b64 exec, s[52:53]
    ds_add_rtn_u32 v26, v101, v1 offset:0
    s_mov_b64 exec, s[54:55]
    ds_add_rtn_u32 v27, v103, v1 offset:0
    s_mov_b64 exec, s[56:57]
    ds_add_rtn_u32 v28, v105, v1 offset:0
    s_mov_b64 exec, s[58:59]
    ds_add_rtn_u32 v29, v107, v1 offset:0
    s_mov_b64 exec, s[60:61]
    ds_add_rtn_u32 v30, v109, v1 offset:0
    s_mov_b64 exec, s[62:63]
    ds_add_rtn_u32 v31, v111, v1 offset:0
    s_mov_b64 exec, -1
    s_cmp_lg_u32 s28, 0
    s_cbranch_scc1 K2_XLDONE
    s_cmp_ge_u32 s3, 9
    s_cbranch_scc1 K2_XL9
    s_cmp_eq_u32 s3, 8
    s_cbranch_scc1 K2_XL8
    v_add_u32 v2, 8192, v127
    v_add_u32 v3, 16384, v127
    global_load_dwordx4 v[56:59], v127, s[10:11]
    global_load_dwordx4 v[64:67], v2, s[10:11]
    global_load_dwordx4 v[60:63], v3, s[10:11]
    s_branch K2_XL7
K2_XL8:
    s_mov_b64 exec, 0xffff
    v_add_u32 v2, 16384, v127
    global_load_dwordx4 v[60:63], v2, s[10:11]
    s_mov_b64 exec, -1
K2_XL7:
    v_add_u32 v2, 16384, v125
    s_mov_b64 exec, s[94:95]
    buffer_load_dwordx4 v[52:55], v2, s[12:15], 0 offen nt
    s_mov_b64 exec, -1
K2_XL9:
    buffer_load_dwordx4 v[48:51], v125, s[12:15], 0 offen nt
K2_XLDONE:
    s_waitcnt lgkmcnt(0)
    s_mov_b64 exec, s[48:49]
    ds_write_b32 v24, v96
    s_mov_b64 exec, s[50:51]
    ds_write_b32 v25, v98
    s_mov_b64 exec, s[52:53]
    ds_write_b32 v26, v100
    s_mov_b64 exec, s[54:55]
    ds_write_b32 v27, v102
    s_mov_b64 exec, s[56:57]
    ds_write_b32 v28, v104
    s_mov_b64 exec, s[58:59]
    ds_write_b32 v29, v106
    s_mov_b64 exec, s[60:61]
    ds_write_b32 v30, v108
    s_mov_b64 exec, s[62:63]
    ds_write_b32 v31, v110
    s_mov_b64 exec, -1
    s_barrier
    s_cmp_eq_u32 s3, 15
    s_cbranch_scc0 K2_SCATDONE
    s_setprio 3
    v_and_b32 v43, 63, v0
    v_lshlrev_b32 v42, 4, v43
    ds_read_b128 v[64:67], v42 offset:0
    s_waitcnt lgkmcnt(0)
    v_mov_b32 v45, 1
    v_mov_b32 v44, 63
    s_mov_b64 s[40:41], 0
    v_lshl_add_u32 v46, v43, 2, 0
    v_mul_u32_u24 v47, 160, v46
    v_add_u32 v47, 121920, v47
    v_sub_u32 v64, v64, v47
    v_lshrrev_b32 v64, 2, v64
    v_cmp_lt_u32 vcc, 195, v46
    v_min_u32 v76, 62, v64
    v_sub_u32 v76, 62, v76
    v_cndmask_b32 v76, v76, v44, vcc
    v_lshlrev_b32 v76, 2, v76
    ds_add_rtn_u32 v80, v76, v45 offset:2048
    v_min_u32 v46, 199, v46
    v_mul_u32_u24 v46, 272, v46
    v_lshl_or_b32 v46, v64, 16, v46
    v_cmp_lt_u32 vcc, 40, v64
    s_or_b64 s[40:41], s[40:41], vcc
    v_lshl_add_u32 v56, v43, 2, 1
    v_mul_u32_u24 v57, 160, v56
    v_add_u32 v57, 121920, v57
    v_sub_u32 v65, v65, v57
    v_lshrrev_b32 v65, 2, v65
    v_cmp_lt_u32 vcc, 195, v56
    v_min_u32 v77, 62, v65
    v_sub_u32 v77, 62, v77
    v_cndmask_b32 v77, v77, v44, vcc
    v_lshlrev_b32 v77, 2, v77
    ds_add_rtn_u32 v81, v77, v45 offset:2048
    v_min_u32 v56, 199, v56
    v_mul_u32_u24 v56, 272, v56
    v_lshl_or_b32 v56, v65, 16, v56
    v_cmp_lt_u32 vcc, 40, v65
    s_or_b64 s[40:41], s[40:41], vcc
    v_lshl_add_u32 v58, v43, 2, 2
    v_mul_u32_u24 v59, 160, v58
    v_add_u32 v59, 121920, v59
    v_sub_u32 v66, v66, v59
    v_lshrrev_b32 v66, 2, v66
    v_cmp_lt_u32 vcc, 195, v58
    v_min_u32 v78, 62, v66
    v_sub_u32 v78, 62, v78
    v_cndmask_b32 v78, v78, v44, vcc
    v_lshlrev_b32 v78, 2, v78
    ds_add_rtn_u32 v82, v78, v45 offset:2048
    v_min_u32 v58, 199, v58
    v_mul_u32_u24 v58, 272, v58
    v_lshl_or_b32 v58, v66, 16, v58
    v_cmp_lt_u32 vcc, 40, v66
    s_or_b64 s[40:41], s[40:41], vcc
    v_lshl_add_u32 v4, v43, 2, 3
    v_mul_u32_u24 v5, 160, v4
    v_add_u32 v5, 121920, v5
    v_sub_u32 v67, v67, v5
    v_lshrrev_b32 v67, 2, v67
    v_cmp_lt_u32 vcc, 195, v4
    v_min_u32 v79, 62, v67
    v_sub_u32 v79, 62, v79
    v_cndmask_b32 v79, v79, v44, vcc
    v_lshlrev_b32 v79, 2, v79
    ds_add_rtn_u32 v83, v79, v45 offset:2048
    v_min_u32 v4, 199, v4
    v_mul_u32_u24 v4, 272, v4
    v_lshl_or_b32 v4, v67, 16, v4
    v_cmp_lt_u32 vcc, 40, v67
    s_or_b64 s[40:41], s[40:41], vcc
    s_cmp_eq_u64 s[40:41], 0
    s_cbranch_scc1 K2_NOOVF
    v_mov_b32 v1, 2564
    v_mov_b32 v2, 1
    ds_write_b32 v1, v2
K2_NOOVF:
    v_lshlrev_b32 v42, 2, v43
    ds_read_b32 v44, v42 offset:2048
    s_waitcnt lgkmcnt(0)
    v_mov_b32 v45, v44
    s_nop 1
    v_add_u32_dpp v45, v45, v45 row_shr:1 row_mask:0xf bank_mask:0xf bound_ctrl:1
    s_nop 1
    v_add_u32_dpp v45, v45, v45 row_shr:2 row_mask:0xf bank_mask:0xf bound_ctrl:1
    s_nop 1
    v_add_u32_dpp v45, v45, v45 row_shr:4 row_mask:0xf bank_mask:0xf bound_ctrl:1
    s_nop 1
    v_add_u32_dpp v45, v45, v45 row_shr:8 row_mask:0xf bank_mask:0xf bound_ctrl:1
    s_nop 1
    v_add_u32_dpp v45, v45, v45 row_bcast:15 row_mask:0xa bank_mask:0xf
    s_nop 1
    v_add_u32_dpp v45, v45, v45 row_bcast:31 row_mask:0xc bank_mask:0xf
    v_sub_u32 v45, v45, v44
    ds_bpermute_b32 v76, v76, v45
    ds_bpermute_b32 v77, v77, v45
    ds_bpermute_b32 v78, v78, v45
    ds_bpermute_b32 v79, v79, v45
    s_waitcnt lgkmcnt(0)
    v_add_u32 v76, v76, v80
    v_lshlrev_b32 v80, 3, v76
    ds_write_b64 v80, v[46:47] offset:2624
    v_and_b32 v80, 0x7f8, v76
    ds_max_u32 v80, v64 offset:2304
    v_sub_u32 v64, 0xffff, v64
    ds_max_u32 v80, v64 offset:2308
    v_add_u32 v77, v77, v81
    v_lshlrev_b32 v81, 3, v77
    ds_write_b64 v81, v[56:57] offset:2624
    v_and_b32 v81, 0x7f8, v77
    ds_max_u32 v81, v65 offset:2304
    v_sub_u32 v65, 0xffff, v65
    ds_max_u32 v81, v65 offset:2308
    v_add_u32 v78, v78, v82
    v_lshlrev_b32 v82, 3, v78
    ds_write_b64 v82, v[58:59] offset:2624
    v_and_b32 v82, 0x7f8, v78
    ds_max_u32 v82, v66 offset:2304
    v_sub_u32 v66, 0xffff, v66
    ds_max_u32 v82, v66 offset:2308
    v_add_u32 v79, v79, v83
    v_lshlrev_b32 v83, 3, v79
    ds_write_b64 v83, v[4:5] offset:2624
    v_and_b32 v83, 0x7f8, v79
    ds_max_u32 v83, v67 offset:2304
    v_sub_u32 v67, 0xffff, v67
    ds_max_u32 v83, v67 offset:2308
    s_setprio 0
K2_SCATDONE:
    s_cmp_lg_u32 s28, 0
    s_cbranch_scc1 K2_NOSTG
    s_waitcnt vmcnt(0)
    ds_write_b128 v6, v[48:51]
    s_cmp_ge_u32 s3, 9
    s_cbranch_scc1 K2_NOSTG
    s_mov_b64 exec, s[94:95]
    ds_write_b128 v6, v[52:55] offset:18432
    s_cmp_eq_u32 s3, 8
    s_cselect_b64 exec, 0xffff, -1
    ds_write_b128 v126, v[60:63]
    s_mov_b64 exec, -1
    s_cbranch_scc1 K2_NOSTG
    ds_write_b128 v7, v[56:59]
    ds_write_b128 v7, v[64:67] offset:8192
K2_NOSTG:
    v_and_b32 v1, 1, v0
    v_lshlrev_b32 v1, 4, v1
    v_mov_b32 v2, 0x3f80
    v_lshlrev_b32 v1, v1, v2
    v_and_b32 v2, 2, v0
    v_cmp_eq_u32 vcc, 0, v2
    v_mov_b32 v2, 0
    s_waitcnt lgkmcnt(0)
    v_cndmask_b32 v44, v2, v1, vcc
    v_cndmask_b32 v45, v1, v2, vcc
    v_and_b32 v46, 56, v0
    s_barrier
    v_mov_b32 v1, 2560
    ds_read_b64 v[6:7], v1
K2_GROUP:
    s_lshl_b32 s40, s33, 6
    s_lshl_b32 s41, s33, 3
    v_add_u32 v1, s40, v46
    v_mov_b32 v2, s41
    ds_read_b64 v[40:41], v1 offset:2624
    ds_read_b64 v[42:43], v2 offset:2304
    s_waitcnt lgkmcnt(0)
    s_cmp_lg_u32 s88, 0
    s_cbranch_scc1 K2_FLAGS
K2_FLAGSOK:
    v_mov_b32 v118, v41
    v_lshrrev_b32 v119, 16, v40
    v_and_b32 v40, 0xffff, v40
    v_add_u32 v120, v40, v121
    v_readfirstlane_b32 s30, v42
    v_readfirstlane_b32 s35, v43
    s_cmp_eq_u32 s96, 0
    s_cbranch_scc1 K2_FIRSTG
    ds_read_u16 v96, v118 offset:0
    ds_read_u16 v97, v118 offset:4
    ds_read_u16 v112, v118 offset:8
    ds_read_u16_d16_hi v116, v118 offset:2
    ds_read_b128 v[80:83], v120 offset:4672
    ds_read_b128 v[84:87], v120 offset:4800
    s_waitcnt lgkmcnt(4)
    v_lshl_add_u32 v96, v96, 7, v121
    buffer_load_dwordx4 v[32:35], v96, s[20:23], 0 offen
    v_lshl_add_u32 v97, v97, 7, v121
    buffer_load_dwordx4 v[36:39], v97, s[20:23], 0 offen
    s_branch K2_GO
K2_FLAGS:
    s_mov_b32 s88, 0
    v_readfirstlane_b32 s32, v6
    v_readfirstlane_b32 s40, v7
    s_nop 3
    s_cmp_eq_u32 s40, 0
    s_cbranch_scc1 K2_FLAGSOK
    s_barrier
    v_mov_b32 v3, 0
    v_lshlrev_b32 v1, 2, v0
    v_cmp_gt_u32 vcc, 256, v0
    s_and_saveexec_b64 s[42:43], vcc
    ds_write_b32 v1, v3 offset:0
    v_cmp_gt_u32 vcc, 128, v0
    s_and_b64 exec, exec, vcc
    ds_write_b32 v1, v3 offset:2048
    s_mov_b64 exec, s[42:43]
    v_mov_b32 v1, 4
    s_waitcnt lgkmcnt(0)
    s_barrier
    s_mov_b64 exec, s[48:49]
    ds_add_rtn_u32 v24, v97, v1 offset:0
    s_mov_b64 exec, s[50:51]
    ds_add_rtn_u32 v25, v99, v1 offset:0
    s_mov_b64 exec, s[52:53]
    ds_add_rtn_u32 v26, v101, v1 offset:0
    s_mov_b64 exec, s[54:55]
    ds_add_rtn_u32 v27, v103, v1 offset:0
    s_mov_b64 exec, s[56:57]
    ds_add_rtn_u32 v28, v105, v1 offset:0
    s_mov_b64 exec, s[58:59]
    ds_add_rtn_u32 v29, v107, v1 offset:0
    s_mov_b64 exec, s[60:61]
    ds_add_rtn_u32 v30, v109, v1 offset:0
    s_mov_b64 exec, s[62:63]
    ds_add_rtn_u32 v31, v111, v1 offset:0
    s_mov_b64 exec, -1
    s_waitcnt lgkmcnt(0)
    s_barrier
    s_cmp_lt_u32 s3, 14
    s_cbranch_scc1 K2_TOC
    v_and_b32 v43, 63, v0
    v_lshlrev_b32 v42, 4, v43
    ds_read_b128 v[64:67], v42 offset:0
    s_waitcnt lgkmcnt(0)
    s_cmp_eq_u32 s3, 14
    s_cbranch_scc0 K2_SORTA
    v_add_u32 v68, v64, v65
    v_add_u32 v69, v68, v66
    v_add_u32 v70, v69, v67
    v_mov_b32 v71, v70
    s_nop 1
    v_add_u32_dpp v71, v71, v71 row_shr:1 row_mask:0xf bank_mask:0xf bound_ctrl:1
    s_nop 1
    v_add_u32_dpp v71, v71, v71 row_shr:2 row_mask:0xf bank_mask:0xf bound_ctrl:1
    s_nop 1
    v_add_u32_dpp v71, v71, v71 row_shr:4 row_mask:0xf bank_mask:0xf bound_ctrl:1
    s_nop 1
    v_add_u32_dpp v71, v71, v71 row_shr:8 row_mask:0xf bank_mask:0xf bound_ctrl:1
    s_nop 1
    v_add_u32_dpp v71, v71, v71 row_bcast:15 row_mask:0xa bank_mask:0xf
    s_nop 1
    v_add_u32_dpp v71, v71, v71 row_bcast:31 row_mask:0xc bank_mask:0xf
    v_sub_u32 v72, v71, v70
    v_add_u32 v72, 121920, v72
    v_add_u32 v73, v72, v64
    v_add_u32 v74, v72, v68
    v_add_u32 v75, v72, v69
    ds_write_b128 v42, v[72:75] offset:1024
    s_waitcnt lgkmcnt(0)
    s_branch K2_TOC
K2_SORTA:
    v_mov_b32 v45, 1
    v_mov_b32 v44, 63
    v_lshl_add_u32 v46, v43, 2, 0
    v_mul_u32_u24 v47, 160, v46
    v_add_u32 v47, 121920, v47
    v_lshrrev_b32 v64, 2, v64
    v_cmp_lt_u32 vcc, 195, v46
    v_min_u32 v76, 62, v64
    v_sub_u32 v76, 62, v76
    v_cndmask_b32 v76, v76, v44, vcc
    v_lshlrev_b32 v76, 2, v76
    ds_add_rtn_u32 v80, v76, v45 offset:2048
    v_min_u32 v46, 199, v46
    v_mul_u32_u24 v46, 272, v46
    v_lshl_or_b32 v46, v64, 16, v46
    v_lshl_add_u32 v56, v43, 2, 1
    v_mul_u32_u24 v57, 160, v56
    v_add_u32 v57, 121920, v57
    v_lshrrev_b32 v65, 2, v65
    v_cmp_lt_u32 vcc, 195, v56
    v_min_u32 v77, 62, v65
    v_sub_u32 v77, 62, v77
    v_cndmask_b32 v77, v77, v44, vcc
    v_lshlrev_b32 v77, 2, v77
    ds_add_rtn_u32 v81, v77, v45 offset:2048
    v_min_u32 v56, 199, v56
    v_mul_u32_u24 v56, 272, v56
    v_lshl_or_b32 v56, v65, 16, v56
    v_lshl_add_u32 v58, v43, 2, 2
    v_mul_u32_u24 v59, 160, v58
    v_add_u32 v59, 121920, v59
    v_lshrrev_b32 v66, 2, v66
    v_cmp_lt_u32 vcc, 195, v58
    v_min_u32 v78, 62, v66
    v_sub_u32 v78, 62, v78
    v_cndmask_b32 v78, v78, v44, vcc
    v_lshlrev_b32 v78, 2, v78
    ds_add_rtn_u32 v82, v78, v45 offset:2048
    v_min_u32 v58, 199, v58
    v_mul_u32_u24 v58, 272, v58
    v_lshl_or_b32 v58, v66, 16, v58
    v_lshl_add_u32 v4, v43, 2, 3
    v_mul_u32_u24 v5, 160, v4
    v_add_u32 v5, 121920, v5
    v_lshrrev_b32 v67, 2, v67
    v_cmp_lt_u32 vcc, 195, v4
    v_min_u32 v79, 62, v67
    v_sub_u32 v79, 62, v79
    v_cndmask_b32 v79, v79, v44, vcc
    v_lshlrev_b32 v79, 2, v79
    ds_add_rtn_u32 v83, v79, v45 offset:2048
    v_min_u32 v4, 199, v4
    v_mul_u32_u24 v4, 272, v4
    v_lshl_or_b32 v4, v67, 16, v4
K2_TOC:
    s_barrier
    s_mov_b64 exec, s[48:49]
    ds_read_b32 v97, v97 offset:1024
    s_mov_b64 exec, s[50:51]
    ds_read_b32 v99, v99 offset:1024
    s_mov_b64 exec, s[52:53]
    ds_read_b32 v101, v101 offset:1024
    s_mov_b64 exec, s[54:55]
    ds_read_b32 v103, v103 offset:1024
    s_mov_b64 exec, s[56:57]
    ds_read_b32 v105, v105 offset:1024
    s_mov_b64 exec, s[58:59]
    ds_read_b32 v107, v107 offset:1024
    s_mov_b64 exec, s[60:61]
    ds_read_b32 v109, v109 offset:1024
    s_mov_b64 exec, s[62:63]
    ds_read_b32 v111, v111 offset:1024
    s_mov_b64 exec, -1
    s_cmp_eq_u32 s3, 15
    s_cbranch_scc0 K2_NOS1
    v_lshlrev_b32 v42, 4, v43
    ds_read_b128 v[72:75], v42 offset:1024
K2_NOS1:
    s_waitcnt lgkmcnt(0)
    s_mov_b64 exec, s[48:49]
    v_add_u32 v97, v97, v24
    ds_write_b32 v97, v96
    s_mov_b64 exec, s[50:51]
    v_add_u32 v99, v99, v25
    ds_write_b32 v99, v98
    s_mov_b64 exec, s[52:53]
    v_add_u32 v101, v101, v26
    ds_write_b32 v101, v100
    s_mov_b64 exec, s[54:55]
    v_add_u32 v103, v103, v27
    ds_write_b32 v103, v102
    s_mov_b64 exec, s[56:57]
    v_add_u32 v105, v105, v28
    ds_write_b32 v105, v104
    s_mov_b64 exec, s[58:59]
    v_add_u32 v107, v107, v29
    ds_write_b32 v107, v106
    s_mov_b64 exec, s[60:61]
    v_add_u32 v109, v109, v30
    ds_write_b32 v109, v108
    s_mov_b64 exec, s[62:63]
    v_add_u32 v111, v111, v31
    ds_write_b32 v111, v110
    s_mov_b64 exec, -1
    s_cmp_eq_u32 s3, 15
    s_cbranch_scc0 K2_XDONE
    v_mov_b32 v47, v72
    v_mov_b32 v57, v73
    v_mov_b32 v59, v74
    v_mov_b32 v5, v75
    v_lshlrev_b32 v42, 2, v43
    ds_read_b32 v44, v42 offset:2048
    s_waitcnt lgkmcnt(0)
    v_mov_b32 v45, v44
    s_nop 1
    v_add_u32_dpp v45, v45, v45 row_shr:1 row_mask:0xf bank_mask:0xf bound_ctrl:1
    s_nop 1
    v_add_u32_dpp v45, v45, v45 row_shr:2 row_mask:0xf bank_mask:0xf bound_ctrl:1
    s_nop 1
    v_add_u32_dpp v45, v45, v45 row_shr:4 row_mask:0xf bank_mask:0xf bound_ctrl:1
    s_nop 1
    v_add_u32_dpp v45, v45, v45 row_shr:8 row_mask:0xf bank_mask:0xf bound_ctrl:1
    s_nop 1
    v_add_u32_dpp v45, v45, v45 row_bcast:15 row_mask:0xa bank_mask:0xf
    s_nop 1
    v_add_u32_dpp v45, v45, v45 row_bcast:31 row_mask:0xc bank_mask:0xf
    v_sub_u32 v45, v45, v44
    ds_bpermute_b32 v76, v76, v45
    ds_bpermute_b32 v77, v77, v45
    ds_bpermute_b32 v78, v78, v45
    ds_bpermute_b32 v79, v79, v45
    s_waitcnt lgkmcnt(0)
    v_add_u32 v76, v76, v80
    v_lshlrev_b32 v80, 3, v76
    ds_write_b64 v80, v[46:47] offset:2624
    v_and_b32 v80, 0x7f8, v76
    ds_max_u32 v80, v64 offset:2304
    v_sub_u32 v64, 0xffff, v64
    ds_max_u32 v80, v64 offset:2308
    v_add_u32 v77, v77, v81
    v_lshlrev_b32 v81, 3, v77
    ds_write_b64 v81, v[56:57] offset:2624
    v_and_b32 v81, 0x7f8, v77
    ds_max_u32 v81, v65 offset:2304
    v_sub_u32 v65, 0xffff, v65
    ds_max_u32 v81, v65 offset:2308
    v_add_u32 v78, v78, v82
    v_lshlrev_b32 v82, 3, v78
    ds_write_b64 v82, v[58:59] offset:2624
    v_and_b32 v82, 0x7f8, v78
    ds_max_u32 v82, v66 offset:2304
    v_sub_u32 v66, 0xffff, v66
    ds_max_u32 v82, v66 offset:2308
    v_add_u32 v79, v79, v83
    v_lshlrev_b32 v83, 3, v79
    ds_write_b64 v83, v[4:5] offset:2624
    v_and_b32 v83, 0x7f8, v79
    ds_max_u32 v83, v67 offset:2304
    v_sub_u32 v67, 0xffff, v67
    ds_max_u32 v83, v67 offset:2308
K2_XDONE:
    v_and_b32 v1, 1, v0
    v_lshlrev_b32 v1, 4, v1
    v_mov_b32 v2, 0x3f80
    v_lshlrev_b32 v1, v1, v2
    v_and_b32 v2, 2, v0
    v_cmp_eq_u32 vcc, 0, v2
    v_mov_b32 v2, 0
    s_waitcnt lgkmcnt(0)
    v_cndmask_b32 v44, v2, v1, vcc
    v_cndmask_b32 v45, v1, v2, vcc
    v_and_b32 v46, 56, v0
    s_barrier
    s_branch K2_GROUP
K2_FIRSTG:
    ds_read_u16 v96, v118 offset:0
    ds_read_u16 v97, v118 offset:4
    s_mov_b32 s96, 1
    s_cmp_ge_u32 s3, 14
    s_cbranch_scc1 K2_FG14
    ds_read_b128 v[48:51], v122 offset:0
    ds_read_b128 v[64:67], v123 offset:0
    ds_read_b128 v[52:55], v122 offset:32
    ds_read_b128 v[68:71], v123 offset:1024
    ds_read_b128 v[56:59], v122 offset:64
    ds_read_b128 v[72:75], v123 offset:2048
    ds_read_b128 v[60:63], v122 offset:96
    ds_read_b128 v[76:79], v123 offset:3072
    s_waitcnt lgkmcnt(8)
    v_lshl_add_u32 v96, v96, 7, v121
    buffer_load_dwordx4 v[32:35], v96, s[20:23], 0 offen
    v_lshl_add_u32 v97, v97, 7, v121
    buffer_load_dwordx4 v[36:39], v97, s[20:23], 0 offen
    v_mov_b32 v47, v124
    ds_read_b128 v[24:27], v123 offset:8192
    ds_read_b128 v[28:31], v123 offset:9216
    ds_read_b128 v[4:7], v123 offset:10240
    ds_read_b128 v[124:127], v123 offset:11264
    s_waitcnt lgkmcnt(10)
    v_mfma_f32_32x32x16_bf16 v[96:111], v[64:67], v[48:51], 0
    s_waitcnt lgkmcnt(8)
    v_mfma_f32_32x32x16_bf16 v[96:111], v[68:71], v[52:55], v[96:111]
    s_waitcnt lgkmcnt(6)
    v_mfma_f32_32x32x16_bf16 v[96:111], v[72:75], v[56:59], v[96:111]
    s_waitcnt lgkmcnt(4)
    v_mfma_f32_32x32x16_bf16 v[96:111], v[76:79], v[60:63], v[96:111]
    s_mov_b32 s42, 3216550459
    s_mov_b32 s43, 3216550459
    v_lshlrev_b32 v1, 1, v121
    v_add_u32 v1, 121664, v1
    ds_read_b128 v[88:91], v1
    ds_read_b128 v[92:95], v1 offset:16
    ds_read_u16 v112, v118 offset:8
    ds_read_u16_d16_hi v116, v118 offset:2
    s_nop 3
    v_pk_mul_f32 v[96:97], v[96:97], s[42:43]
    v_pk_mul_f32 v[98:99], v[98:99], s[42:43]
    v_pk_mul_f32 v[100:101], v[100:101], s[42:43]
    v_pk_mul_f32 v[102:103], v[102:103], s[42:43]
    v_pk_mul_f32 v[104:105], v[104:105], s[42:43]
    v_pk_mul_f32 v[106:107], v[106:107], s[42:43]
    v_pk_mul_f32 v[108:109], v[108:109], s[42:43]
    v_pk_mul_f32 v[110:111], v[110:111], s[42:43]
    s_mov_b64 exec, s[100:101]
    ds_write_b128 v47, v[96:99] offset:4672
    ds_write_b128 v47, v[100:103] offset:4800
    ds_write_b128 v47, v[104:107] offset:4688
    ds_write_b128 v47, v[108:111] offset:4816
    s_mov_b64 exec, -1
    s_branch K2_QDONE
K2_FG14:
    s_waitcnt lgkmcnt(0)
    v_lshl_add_u32 v96, v96, 7, v121
    buffer_load_dwordx4 v[32:35], v96, s[20:23], 0 offen
    v_lshl_add_u32 v97, v97, 7, v121
    buffer_load_dwordx4 v[36:39], v97, s[20:23], 0 offen
    v_lshlrev_b32 v1, 1, v121
    v_add_u32 v1, 121664, v1
    ds_read_b128 v[88:91], v1
    ds_read_b128 v[92:95], v1 offset:16
    ds_read_u16 v112, v118 offset:8
    ds_read_u16_d16_hi v116, v118 offset:2
K2_QDONE:
    s_waitcnt lgkmcnt(0)
    s_barrier
    ds_read_b128 v[80:83], v120 offset:4672
    ds_read_b128 v[84:87], v120 offset:4800
    s_cmp_ge_u32 s3, 14
    s_cbranch_scc1 K2_NOU0
    v_mfma_f32_32x32x16_bf16 v[8:23], v[24:27], v[48:51], 0
    v_mfma_f32_32x32x16_bf16 v[8:23], v[28:31], v[52:55], v[8:23]
    v_mfma_f32_32x32x16_bf16 v[8:23], v[4:7], v[56:59], v[8:23]
    v_mfma_f32_32x32x16_bf16 v[8:23], v[124:127], v[60:63], v[8:23]
K2_NOU0:
K2_GO:
    s_sub_u32 s35, 0xffff, s35
    s_sub_i32 s31, s30, 2
    s_mov_b32 s91, 0
    s_mov_b32 s29, 0
    s_cmp_eq_u32 s35, 0
    s_cbranch_scc1 K2_INIT0
    s_waitcnt lgkmcnt(0)
    v_pk_fma_f32 v[64:65], v[116:117], v[88:89], v[80:81] op_sel:[0,0,0] op_sel_hi:[0,1,1]
    v_pk_fma_f32 v[66:67], v[116:117], v[90:91], v[82:83] op_sel:[0,0,0] op_sel_hi:[0,1,1]
    v_pk_fma_f32 v[68:69], v[116:117], v[92:93], v[84:85] op_sel:[0,0,0] op_sel_hi:[0,1,1]
    v_pk_fma_f32 v[70:71], v[116:117], v[94:95], v[86:87] op_sel:[0,0,0] op_sel_hi:[0,1,1]
    s_cmp_lt_i32 s29, s31
    s_waitcnt vmcnt(1)
    v_mfma_f32_4x4x4_16b_bf16 v[64:67], v[44:45], v[32:33], v[64:67]
    v_mfma_f32_4x4x4_16b_bf16 v[68:71], v[44:45], v[34:35], v[68:71]
    s_cselect_b32 s18, s93, 0
    buffer_load_dwordx4 v[32:35], v[112:113], s[16:19], 0 idxen offen
    ds_read_u16 v114, v118 offset:12
    ds_read_u16_d16_hi v117, v118 offset:6
    v_exp_f32 v104, v64
    s_mov_b32 s29, 1
    v_exp_f32 v105, v65
    s_cmp_eq_u32 s30, 1
    v_exp_f32 v106, v66
    v_exp_f32 v107, v67
    v_exp_f32 v108, v68
    v_exp_f32 v109, v69
    v_exp_f32 v110, v70
    v_exp_f32 v111, v71
    v_pk_add_f32 v[72:73], v[104:105], 1.0 op_sel_hi:[1,0]
    v_pk_add_f32 v[74:75], v[106:107], 1.0 op_sel_hi:[1,0]
    v_pk_add_f32 v[76:77], v[108:109], 1.0 op_sel_hi:[1,0]
    v_pk_add_f32 v[78:79], v[110:111], 1.0 op_sel_hi:[1,0]
    s_cbranch_scc1 K2_CLOSE
    s_branch K2_STEP1
K2_INIT0:
    v_mov_b32 v64, 0
    v_mov_b32 v72, 1.0
    v_mov_b32 v65, 0
    v_mov_b32 v73, 1.0
    v_mov_b32 v66, 0
    v_mov_b32 v74, 1.0
    v_mov_b32 v67, 0
    v_mov_b32 v75, 1.0
    v_mov_b32 v68, 0
    v_mov_b32 v76, 1.0
    v_mov_b32 v69, 0
    v_mov_b32 v77, 1.0
    v_mov_b32 v70, 0
    v_mov_b32 v78, 1.0
    v_mov_b32 v71, 0
    v_mov_b32 v79, 1.0
    s_cmp_eq_u32 s30, 0
    s_cbranch_scc1 K2_CLOSE
K2_LOOP:
    s_waitcnt lgkmcnt(0)
    v_pk_fma_f32 v[96:97], v[116:117], v[88:89], v[80:81] op_sel:[0,0,0] op_sel_hi:[0,1,1]
    v_pk_fma_f32 v[98:99], v[116:117], v[90:91], v[82:83] op_sel:[0,0,0] op_sel_hi:[0,1,1]
    v_pk_fma_f32 v[100:101], v[116:117], v[92:93], v[84:85] op_sel:[0,0,0] op_sel_hi:[0,1,1]
    v_pk_fma_f32 v[102:103], v[116:117], v[94:95], v[86:87] op_sel:[0,0,0] op_sel_hi:[0,1,1]
    s_cmp_lt_i32 s29, s31
    s_waitcnt vmcnt(1)
    v_mfma_f32_4x4x4_16b_bf16 v[96:99], v[44:45], v[32:33], v[96:99]
    v_mfma_f32_4x4x4_16b_bf16 v[100:103], v[44:45], v[34:35], v[100:103]
    s_cselect_b32 s18, s93, 0
    buffer_load_dwordx4 v[32:35], v[112:113], s[16:19], 0 idxen offen
    ds_read_u16 v114, v118 offset:12
    ds_read_u16_d16_hi v117, v118 offset:6
    v_exp_f32 v104, v96
    s_cmp_ge_u32 s29, s35
    v_exp_f32 v105, v97
    s_cbranch_scc1 K2_MASK0
K2_BACK0:
    v_exp_f32 v106, v98
    s_add_u32 s29, s29, 1
    v_exp_f32 v107, v99
    v_exp_f32 v108, v100
    v_exp_f32 v109, v101
    v_exp_f32 v110, v102
    v_exp_f32 v111, v103
    v_pk_fma_f32 v[64:65], v[64:65], v[104:105], v[64:65]
    v_pk_fma_f32 v[66:67], v[66:67], v[106:107], v[66:67]
    v_pk_fma_f32 v[68:69], v[68:69], v[108:109], v[68:69]
    v_pk_fma_f32 v[70:71], v[70:71], v[110:111], v[70:71]
    v_pk_fma_f32 v[64:65], v[96:97], v[72:73], v[64:65]
    v_pk_fma_f32 v[66:67], v[98:99], v[74:75], v[66:67]
    v_pk_fma_f32 v[68:69], v[100:101], v[76:77], v[68:69]
    v_pk_fma_f32 v[70:71], v[102:103], v[78:79], v[70:71]
    s_cmp_eq_u32 s29, s30
    v_pk_fma_f32 v[72:73], v[72:73], v[104:105], v[72:73]
    v_pk_fma_f32 v[74:75], v[74:75], v[106:107], v[74:75]
    v_pk_fma_f32 v[76:77], v[76:77], v[108:109], v[76:77]
    v_pk_fma_f32 v[78:79], v[78:79], v[110:111], v[78:79]
    s_mov_b64 exec, -1
    s_cbranch_scc1 K2_CLOSE
K2_STEP1:
    s_waitcnt lgkmcnt(0)
    v_pk_fma_f32 v[96:97], v[116:117], v[88:89], v[80:81] op_sel:[1,0,0] op_sel_hi:[1,1,1]
    v_pk_fma_f32 v[98:99], v[116:117], v[90:91], v[82:83] op_sel:[1,0,0] op_sel_hi:[1,1,1]
    v_pk_fma_f32 v[100:101], v[116:117], v[92:93], v[84:85] op_sel:[1,0,0] op_sel_hi:[1,1,1]
    v_pk_fma_f32 v[102:103], v[116:117], v[94:95], v[86:87] op_sel:[1,0,0] op_sel_hi:[1,1,1]
    s_cmp_lt_i32 s29, s31
    s_waitcnt vmcnt(1)
    v_mfma_f32_4x4x4_16b_bf16 v[96:99], v[44:45], v[36:37], v[96:99]
    v_mfma_f32_4x4x4_16b_bf16 v[100:103], v[44:45], v[38:39], v[100:103]
    s_cselect_b32 s18, s93, 0
    buffer_load_dwordx4 v[36:39], v[114:115], s[16:19], 0 idxen offen
    ds_read_u16 v112, v118 offset:16
    ds_read_u16_d16_hi v116, v118 offset:10
    v_exp_f32 v104, v96
    s_cmp_ge_u32 s29, s35
    v_exp_f32 v105, v97
    s_cbranch_scc1 K2_MASK1
K2_BACK1:
    v_exp_f32 v106, v98
    s_add_u32 s29, s29, 1
    v_exp_f32 v107, v99
    v_exp_f32 v108, v100
    v_exp_f32 v109, v101
    v_exp_f32 v110, v102
    v_exp_f32 v111, v103
    v_pk_fma_f32 v[64:65], v[64:65], v[104:105], v[64:65]
    v_pk_fma_f32 v[66:67], v[66:67], v[106:107], v[66:67]
    v_pk_fma_f32 v[68:69], v[68:69], v[108:109], v[68:69]
    v_pk_fma_f32 v[70:71], v[70:71], v[110:111], v[70:71]
    v_pk_fma_f32 v[64:65], v[96:97], v[72:73], v[64:65]
    v_pk_fma_f32 v[66:67], v[98:99], v[74:75], v[66:67]
    v_pk_fma_f32 v[68:69], v[100:101], v[76:77], v[68:69]
    v_pk_fma_f32 v[70:71], v[102:103], v[78:79], v[70:71]
    s_cmp_eq_u32 s29, s30
    v_pk_fma_f32 v[72:73], v[72:73], v[104:105], v[72:73]
    v_pk_fma_f32 v[74:75], v[74:75], v[106:107], v[74:75]
    v_pk_fma_f32 v[76:77], v[76:77], v[108:109], v[76:77]
    v_pk_fma_f32 v[78:79], v[78:79], v[110:111], v[78:79]
    s_mov_b64 exec, -1
    s_cbranch_scc1 K2_CLOSE
    s_waitcnt lgkmcnt(0)
    v_pk_fma_f32 v[96:97], v[116:117], v[88:89], v[80:81] op_sel:[0,0,0] op_sel_hi:[0,1,1]
    v_pk_fma_f32 v[98:99], v[116:117], v[90:91], v[82:83] op_sel:[0,0,0] op_sel_hi:[0,1,1]
    v_pk_fma_f32 v[100:101], v[116:117], v[92:93], v[84:85] op_sel:[0,0,0] op_sel_hi:[0,1,1]
    v_pk_fma_f32 v[102:103], v[116:117], v[94:95], v[86:87] op_sel:[0,0,0] op_sel_hi:[0,1,1]
    s_cmp_lt_i32 s29, s31
    s_waitcnt vmcnt(1)
    v_mfma_f32_4x4x4_16b_bf16 v[96:99], v[44:45], v[32:33], v[96:99]
    v_mfma_f32_4x4x4_16b_bf16 v[100:103], v[44:45], v[34:35], v[100:103]
    s_cselect_b32 s18, s93, 0
    buffer_load_dwordx4 v[32:35], v[112:113], s[16:19], 0 idxen offen
    ds_read_u16 v114, v118 offset:20
    ds_read_u16_d16_hi v117, v118 offset:14
    v_exp_f32 v104, v96
    s_cmp_ge_u32 s29, s35
    v_exp_f32 v105, v97
    s_cbranch_scc1 K2_MASK2
K2_BACK2:
    v_exp_f32 v106, v98
    s_add_u32 s29, s29, 1
    v_exp_f32 v107, v99
    v_exp_f32 v108, v100
    v_exp_f32 v109, v101
    v_exp_f32 v110, v102
    v_exp_f32 v111, v103
    v_pk_fma_f32 v[64:65], v[64:65], v[104:105], v[64:65]
    v_pk_fma_f32 v[66:67], v[66:67], v[106:107], v[66:67]
    v_pk_fma_f32 v[68:69], v[68:69], v[108:109], v[68:69]
    v_pk_fma_f32 v[70:71], v[70:71], v[110:111], v[70:71]
    v_pk_fma_f32 v[64:65], v[96:97], v[72:73], v[64:65]
    v_pk_fma_f32 v[66:67], v[98:99], v[74:75], v[66:67]
    v_pk_fma_f32 v[68:69], v[100:101], v[76:77], v[68:69]
    v_pk_fma_f32 v[70:71], v[102:103], v[78:79], v[70:71]
    s_cmp_eq_u32 s29, s30
    v_pk_fma_f32 v[72:73], v[72:73], v[104:105], v[72:73]
    v_pk_fma_f32 v[74:75], v[74:75], v[106:107], v[74:75]
    v_pk_fma_f32 v[76:77], v[76:77], v[108:109], v[76:77]
    v_pk_fma_f32 v[78:79], v[78:79], v[110:111], v[78:79]
    s_mov_b64 exec, -1
    s_cbranch_scc1 K2_CLOSE
    s_waitcnt lgkmcnt(0)
    v_pk_fma_f32 v[96:97], v[116:117], v[88:89], v[80:81] op_sel:[1,0,0] op_sel_hi:[1,1,1]
    v_pk_fma_f32 v[98:99], v[116:117], v[90:91], v[82:83] op_sel:[1,0,0] op_sel_hi:[1,1,1]
    v_pk_fma_f32 v[100:101], v[116:117], v[92:93], v[84:85] op_sel:[1,0,0] op_sel_hi:[1,1,1]
    v_pk_fma_f32 v[102:103], v[116:117], v[94:95], v[86:87] op_sel:[1,0,0] op_sel_hi:[1,1,1]
    s_cmp_lt_i32 s29, s31
    s_waitcnt vmcnt(1)
    v_mfma_f32_4x4x4_16b_bf16 v[96:99], v[44:45], v[36:37], v[96:99]
    v_mfma_f32_4x4x4_16b_bf16 v[100:103], v[44:45], v[38:39], v[100:103]
    s_cselect_b32 s18, s93, 0
    buffer_load_dwordx4 v[36:39], v[114:115], s[16:19], 0 idxen offen
    ds_read_u16 v112, v118 offset:24
    ds_read_u16_d16_hi v116, v118 offset:18
    v_exp_f32 v104, v96
    s_cmp_ge_u32 s29, s35
    v_exp_f32 v105, v97
    s_cbranch_scc1 K2_MASK3
K2_BACK3:
    v_exp_f32 v106, v98
    s_add_u32 s29, s29, 1
    v_exp_f32 v107, v99
    v_exp_f32 v108, v100
    v_exp_f32 v109, v101
    v_exp_f32 v110, v102
    v_exp_f32 v111, v103
    v_pk_fma_f32 v[64:65], v[64:65], v[104:105], v[64:65]
    v_pk_fma_f32 v[66:67], v[66:67], v[106:107], v[66:67]
    v_pk_fma_f32 v[68:69], v[68:69], v[108:109], v[68:69]
    v_pk_fma_f32 v[70:71], v[70:71], v[110:111], v[70:71]
    v_pk_fma_f32 v[64:65], v[96:97], v[72:73], v[64:65]
    v_pk_fma_f32 v[66:67], v[98:99], v[74:75], v[66:67]
    v_pk_fma_f32 v[68:69], v[100:101], v[76:77], v[68:69]
    v_pk_fma_f32 v[70:71], v[102:103], v[78:79], v[70:71]
    s_cmp_eq_u32 s29, s30
    v_pk_fma_f32 v[72:73], v[72:73], v[104:105], v[72:73]
    v_pk_fma_f32 v[74:75], v[74:75], v[106:107], v[74:75]
    v_pk_fma_f32 v[76:77], v[76:77], v[108:109], v[76:77]
    v_pk_fma_f32 v[78:79], v[78:79], v[110:111], v[78:79]
    s_mov_b64 exec, -1
    s_cbranch_scc1 K2_CLOSE
    v_add_u32 v118, 16, v118
    s_add_u32 s91, s91, 16
    s_branch K2_LOOP
K2_MASK0:
    v_cmp_lt_u32 vcc, s29, v119
    s_mov_b64 exec, vcc
    s_branch K2_BACK0
K2_MASK1:
    v_cmp_lt_u32 vcc, s29, v119
    s_mov_b64 exec, vcc
    s_branch K2_BACK1
K2_MASK2:
    v_cmp_lt_u32 vcc, s29, v119
    s_mov_b64 exec, vcc
    s_branch K2_BACK2
K2_MASK3:
    v_cmp_lt_u32 vcc, s29, v119
    s_mov_b64 exec, vcc
    s_branch K2_BACK3
K2_CLOSE:
    s_waitcnt lgkmcnt(0)
    v_rcp_f32 v104, v72
    v_rcp_f32 v105, v73
    v_rcp_f32 v106, v74
    v_rcp_f32 v107, v75
    v_rcp_f32 v108, v76
    v_rcp_f32 v109, v77
    v_rcp_f32 v110, v78
    v_rcp_f32 v111, v79
    s_nop 0
    v_pk_mul_f32 v[104:105], v[104:105], s[36:37]
    v_pk_mul_f32 v[106:107], v[106:107], s[36:37]
    v_pk_mul_f32 v[108:109], v[108:109], s[36:37]
    v_pk_mul_f32 v[110:111], v[110:111], s[36:37]
    v_pk_mul_f32 v[96:97], v[64:65], v[104:105]
    v_pk_mul_f32 v[98:99], v[66:67], v[106:107]
    v_pk_mul_f32 v[100:101], v[68:69], v[108:109]
    v_pk_mul_f32 v[102:103], v[70:71], v[110:111]
    v_pk_fma_f32 v[104:105], v[72:73], 0, v[96:97] op_sel_hi:[1,0,1]
    v_pk_fma_f32 v[106:107], v[74:75], 0, v[98:99] op_sel_hi:[1,0,1]
    v_pk_fma_f32 v[108:109], v[76:77], 0, v[100:101] op_sel_hi:[1,0,1]
    v_pk_fma_f32 v[110:111], v[78:79], 0, v[102:103] op_sel_hi:[1,0,1]
    v_pk_add_f32 v[104:105], v[104:105], v[106:107]
    v_pk_add_f32 v[108:109], v[108:109], v[110:111]
    v_pk_add_f32 v[104:105], v[104:105], v[108:109]
    v_add_f32 v104, v104, v105
    v_cmp_class_f32_e64 vcc, v104, s38
    s_cbranch_vccnz K2_SLOW
K2_WRITE:
    s_cmp_eq_u32 s28, 0
    s_cbranch_scc1 K2_WR0
    ds_read_b128 v[104:107], v120 offset:59072
    ds_read_b128 v[108:111], v120 offset:59200
    s_waitcnt lgkmcnt(0)
    v_pk_add_f32 v[96:97], v[96:97], v[104:105]
    v_pk_add_f32 v[98:99], v[98:99], v[106:107]
    v_pk_add_f32 v[100:101], v[100:101], v[108:109]
    v_pk_add_f32 v[102:103], v[102:103], v[110:111]
K2_WR0:
    ds_write_b128 v120, v[96:99] offset:59072
    ds_write_b128 v120, v[100:103] offset:59200
    s_mov_b32 s33, s39
    s_mov_b32 s39, 0xff
    s_cmp_lg_u32 s33, 0xff
    s_cbranch_scc1 K2_GROUP
    s_branch K2_GROUPS_DONE
K2_SLOW:
    s_waitcnt vmcnt(0)
    s_mov_b32 s18, s93
    v_subrev_u32 v118, s91, v118
    s_mov_b32 s29, 0
    v_mov_b32 v64, 0
    v_mov_b32 v65, 0
    v_mov_b32 v66, 0
    v_mov_b32 v67, 0
    v_mov_b32 v68, 0
    v_mov_b32 v69, 0
    v_mov_b32 v70, 0
    v_mov_b32 v71, 0
K2_SLOOP:
    ds_read_u16 v112, v118
    ds_read_u16_d16_hi v116, v118 offset:2
    s_waitcnt lgkmcnt(0)
    buffer_load_dwordx4 v[32:35], v[112:113], s[16:19], 0 idxen offen
    s_waitcnt vmcnt(0)
    v_pk_fma_f32 v[96:97], v[116:117], v[88:89], v[80:81] op_sel:[0,0,0] op_sel_hi:[0,1,1]
    v_pk_fma_f32 v[98:99], v[116:117], v[90:91], v[82:83] op_sel:[0,0,0] op_sel_hi:[0,1,1]
    v_pk_fma_f32 v[100:101], v[116:117], v[92:93], v[84:85] op_sel:[0,0,0] op_sel_hi:[0,1,1]
    v_pk_fma_f32 v[102:103], v[116:117], v[94:95], v[86:87] op_sel:[0,0,0] op_sel_hi:[0,1,1]
    s_nop 1
    v_mfma_f32_4x4x4_16b_bf16 v[96:99], v[44:45], v[32:33], v[96:99]
    v_mfma_f32_4x4x4_16b_bf16 v[100:103], v[44:45], v[34:35], v[100:103]
    s_nop 5
    v_exp_f32 v104, v96
    v_exp_f32 v105, v97
    v_exp_f32 v106, v98
    v_exp_f32 v107, v99
    v_exp_f32 v108, v100
    v_exp_f32 v109, v101
    v_exp_f32 v110, v102
    v_exp_f32 v111, v103
    s_nop 0
    v_add_f32 v104, 1.0, v104
    v_add_f32 v105, 1.0, v105
    v_add_f32 v106, 1.0, v106
    v_add_f32 v107, 1.0, v107
    v_add_f32 v108, 1.0, v108
    v_add_f32 v109, 1.0, v109
    v_add_f32 v110, 1.0, v110
    v_add_f32 v111, 1.0, v111
    v_rcp_f32 v104, v104
    v_rcp_f32 v105, v105
    v_rcp_f32 v106, v106
    v_rcp_f32 v107, v107
    v_rcp_f32 v108, v108
    v_rcp_f32 v109, v109
    v_rcp_f32 v110, v110
    v_rcp_f32 v111, v111
    v_cmp_lt_u32 vcc, s29, v119
    s_add_u32 s29, s29, 1
    s_mov_b64 exec, vcc
    v_fmac_f32 v64, v96, v104
    v_fmac_f32 v65, v97, v105
    v_fmac_f32 v66, v98, v106
    v_fmac_f32 v67, v99, v107
    v_fmac_f32 v68, v100, v108
    v_fmac_f32 v69, v101, v109
    v_fmac_f32 v70, v102, v110
    v_fmac_f32 v71, v103, v111
    s_mov_b64 exec, -1
    v_add_u32 v118, 4, v118
    s_cmp_lt_u32 s29, s30
    s_cbranch_scc1 K2_SLOOP
    v_pk_mul_f32 v[96:97], v[64:65], s[36:37]
    v_pk_mul_f32 v[98:99], v[66:67], s[36:37]
    v_pk_mul_f32 v[100:101], v[68:69], s[36:37]
    v_pk_mul_f32 v[102:103], v[70:71], s[36:37]
    s_branch K2_WRITE
K2_GROUPS_DONE:
    s_waitcnt vmcnt(0)
    s_cmp_eq_u32 s32, 0
    s_cbranch_scc1 K2_EPI
    s_waitcnt lgkmcnt(0)
    s_barrier
    s_add_u32 s28, s28, 1
    v_lshrrev_b32 v29, 3, v0
    v_lshlrev_b32 v2, 10, v29
    v_and_b32 v28, 7, v0
    v_mul_u32_u24 v30, 25088, v29
    v_lshl_add_u32 v30, v28, 4, v30
    v_lshlrev_b32 v28, 1, v28
    s_branch K2_PASS
K2_EPI:
    s_cmp_ge_u32 s3, 14
    s_cbranch_scc1 K2_EPI_IDLE
    s_and_b32 s41, s3, 1
    s_lshr_b32 s40, s3, 1
    s_lshl_b32 s40, s40, 5
    v_and_b32 v4, 31, v0
    v_add_u32 v122, s40, v4
    v_bfe_u32 v123, v0, 5, 1
    v_mul_u32_u24 v1, 272, v122
    v_lshl_add_u32 v1, v123, 4, v1
    s_lshl_b32 s42, s41, 12
    s_add_u32 s42, s42, 113472
    v_and_b32 v3, 63, v0
    v_lshlrev_b32 v2, 4, v3
    v_add_u32 v2, s42, v2
    ds_read_b128 v[48:51], v2
    ds_read_b128 v[52:55], v2 offset:1024
    ds_read_b128 v[56:59], v2 offset:2048
    ds_read_b128 v[60:63], v2 offset:3072
    s_mul_i32 s42, s3, 2560
    v_mul_u32_u24 v6, 80, v4
    v_lshl_add_u32 v6, v123, 5, v6
    v_add_u32 v6, s42, v6
    v_lshrrev_b32 v2, 2, v3
    v_and_b32 v3, 3, v3
    v_mul_u32_u24 v7, 80, v2
    v_lshl_add_u32 v7, v3, 4, v7
    v_add_u32 v7, s42, v7
    v_add_u32 v2, s40, v2
    v_add_u32 v5, s34, v2
    v_lshlrev_b32 v5, 7, v5
    v_lshl_add_u32 v5, v3, 4, v5
    s_lshl_b32 s41, s41, 6
    v_add_u32 v5, s41, v5
    s_movk_i32 s40, 196
    v_cmp_gt_u32 s[100:101], s40, v2
    v_add_u32 v2, 16, v2
    v_cmp_gt_u32 s[94:95], s40, v2
    s_mov_b32 s42, 3216550459
    s_mov_b32 s43, 3216550459
    s_waitcnt lgkmcnt(0)
    s_barrier
    ds_read_b128 v[64:67], v1 offset:59072
    ds_read_b128 v[68:71], v1 offset:59200
    ds_read_b128 v[72:75], v1 offset:59104
    ds_read_b128 v[76:79], v1 offset:59232
    ds_read_b128 v[80:83], v1 offset:59136
    ds_read_b128 v[84:87], v1 offset:59264
    ds_read_b128 v[88:91], v1 offset:59168
    ds_read_b128 v[92:95], v1 offset:59296
    s_waitcnt lgkmcnt(6)
    v_cvt_pk_bf16_f32 v32, v64, v65
    v_cvt_pk_bf16_f32 v33, v66, v67
    v_cvt_pk_bf16_f32 v34, v68, v69
    v_cvt_pk_bf16_f32 v35, v70, v71
    s_waitcnt lgkmcnt(4)
    v_cvt_pk_bf16_f32 v36, v72, v73
    v_cvt_pk_bf16_f32 v37, v74, v75
    v_cvt_pk_bf16_f32 v38, v76, v77
    v_cvt_pk_bf16_f32 v39, v78, v79
    v_mfma_f32_32x32x16_bf16 v[8:23], v[48:51], v[32:35], v[8:23]
    s_waitcnt lgkmcnt(2)
    v_cvt_pk_bf16_f32 v40, v80, v81
    v_cvt_pk_bf16_f32 v41, v82, v83
    v_cvt_pk_bf16_f32 v42, v84, v85
    v_cvt_pk_bf16_f32 v43, v86, v87
    v_mfma_f32_32x32x16_bf16 v[8:23], v[52:55], v[36:39], v[8:23]
    s_waitcnt lgkmcnt(0)
    v_cvt_pk_bf16_f32 v44, v88, v89
    v_cvt_pk_bf16_f32 v45, v90, v91
    v_cvt_pk_bf16_f32 v46, v92, v93
    v_cvt_pk_bf16_f32 v47, v94, v95
    v_mfma_f32_32x32x16_bf16 v[8:23], v[56:59], v[40:43], v[8:23]
    s_nop 1
    v_mfma_f32_32x32x16_bf16 v[8:23], v[60:63], v[44:47], v[8:23]
    s_nop 7
    s_nop 3
    v_pk_mul_f32 v[32:33], v[8:9], s[42:43]
    v_pk_mul_f32 v[34:35], v[10:11], s[42:43]
    v_pk_mul_f32 v[36:37], v[12:13], s[42:43]
    v_pk_mul_f32 v[38:39], v[14:15], s[42:43]
    v_pk_mul_f32 v[40:41], v[16:17], s[42:43]
    v_pk_mul_f32 v[42:43], v[18:19], s[42:43]
    v_pk_mul_f32 v[44:45], v[20:21], s[42:43]
    v_pk_mul_f32 v[46:47], v[22:23], s[42:43]
    v_exp_f32 v32, v32
    v_exp_f32 v33, v33
    v_exp_f32 v34, v34
    v_exp_f32 v35, v35
    v_exp_f32 v36, v36
    v_exp_f32 v37, v37
    v_exp_f32 v38, v38
    v_exp_f32 v39, v39
    v_exp_f32 v40, v40
    v_exp_f32 v41, v41
    v_exp_f32 v42, v42
    v_exp_f32 v43, v43
    v_exp_f32 v44, v44
    v_exp_f32 v45, v45
    v_exp_f32 v46, v46
    v_exp_f32 v47, v47
    v_pk_add_f32 v[32:33], v[32:33], 1.0 op_sel_hi:[1,0]
    v_pk_add_f32 v[34:35], v[34:35], 1.0 op_sel_hi:[1,0]
    v_pk_add_f32 v[36:37], v[36:37], 1.0 op_sel_hi:[1,0]
    v_pk_add_f32 v[38:39], v[38:39], 1.0 op_sel_hi:[1,0]
    v_pk_add_f32 v[40:41], v[40:41], 1.0 op_sel_hi:[1,0]
    v_pk_add_f32 v[42:43], v[42:43], 1.0 op_sel_hi:[1,0]
    v_pk_add_f32 v[44:45], v[44:45], 1.0 op_sel_hi:[1,0]
    v_pk_add_f32 v[46:47], v[46:47], 1.0 op_sel_hi:[1,0]
    v_rcp_f32 v32, v32
    v_rcp_f32 v33, v33
    v_rcp_f32 v34, v34
    v_rcp_f32 v35, v35
    v_rcp_f32 v36, v36
    v_rcp_f32 v37, v37
    v_rcp_f32 v38, v38
    v_rcp_f32 v39, v39
    v_rcp_f32 v40, v40
    v_rcp_f32 v41, v41
    v_rcp_f32 v42, v42
    v_rcp_f32 v43, v43
    v_rcp_f32 v44, v44
    v_rcp_f32 v45, v45
    v_rcp_f32 v46, v46
    v_rcp_f32 v47, v47
    v_pk_mul_f32 v[32:33], v[8:9], v[32:33]
    v_pk_mul_f32 v[34:35], v[10:11], v[34:35]
    v_pk_mul_f32 v[36:37], v[12:13], v[36:37]
    v_pk_mul_f32 v[38:39], v[14:15], v[38:39]
    v_pk_mul_f32 v[40:41], v[16:17], v[40:41]
    v_pk_mul_f32 v[42:43], v[18:19], v[42:43]
    v_pk_mul_f32 v[44:45], v[20:21], v[44:45]
    v_pk_mul_f32 v[46:47], v[22:23], v[46:47]
    v_cvt_pk_bf16_f32 v48, v32, v33
    v_cvt_pk_bf16_f32 v49, v34, v35
    v_cvt_pk_bf16_f32 v50, v36, v37
    v_cvt_pk_bf16_f32 v51, v38, v39
    v_cvt_pk_bf16_f32 v52, v40, v41
    v_cvt_pk_bf16_f32 v53, v42, v43
    v_cvt_pk_bf16_f32 v54, v44, v45
    v_cvt_pk_bf16_f32 v55, v46, v47
    ds_write_b128 v6, v[48:51] offset:4672
    ds_write_b128 v6, v[52:55] offset:4688
    s_waitcnt lgkmcnt(0)
    ds_read_b128 v[56:59], v7 offset:4672
    ds_read_b128 v[60:63], v7 offset:5952
    s_mov_b64 exec, s[100:101]
    s_waitcnt lgkmcnt(1)
    buffer_store_dwordx4 v[56:59], v5, s[24:27], 0 offen sc1
    s_mov_b64 exec, s[94:95]
    s_waitcnt lgkmcnt(0)
    buffer_store_dwordx4 v[60:63], v5, s[24:27], 0 offen offset:2048 sc1
K2_FIN:
    s_endpgm
K2_EPI_IDLE:
    s_waitcnt lgkmcnt(0)
    s_barrier
K2_END:
    s_endpgm
.section .rodata,"a"
.p2align 6
.amdhsa_kernel k1_kernel
  .amdhsa_next_free_vgpr 96
  .amdhsa_next_free_sgpr 96
  .amdhsa_accum_offset 96
  .amdhsa_group_segment_fixed_size 0
  .amdhsa_kernarg_size 72
  .amdhsa_user_sgpr_count 2
  .amdhsa_user_sgpr_kernarg_segment_ptr 1
  .amdhsa_system_sgpr_workgroup_id_x 1
  .amdhsa_float_denorm_mode_32 3
.end_amdhsa_kernel
.p2align 6
.amdhsa_kernel k2_kernel
  .amdhsa_next_free_vgpr 128
  .amdhsa_next_free_sgpr 102
  .amdhsa_accum_offset 128
  .amdhsa_group_segment_fixed_size 0
  .amdhsa_kernarg_size 72
  .amdhsa_user_sgpr_count 2
  .amdhsa_user_sgpr_kernarg_segment_ptr 1
  .amdhsa_system_sgpr_workgroup_id_x 1
  .amdhsa_float_denorm_mode_32 3
.end_amdhsa_kernel
```
